```python
import torch

def _softmax(x, axis=-1):
    return torch.softmax(x, dim=axis)
def _gelu(x):
    return torch.nn.functional.gelu(x, approximate="tanh")
def _silu(x):
    return torch.nn.functional.silu(x)
def _sigmoid(x):
    return torch.sigmoid(x)
def _layernorm(x, axis=-1, eps=1e-5):
    m = x.mean(dim=axis, keepdim=True)
    v = x.var(dim=axis, keepdim=True, unbiased=False)
    return (x - m) / torch.sqrt(v + eps)
def _scatter_add(tgt, idx, src, axis=0):
    return tgt.clone().index_add_(axis, idx, src)
def _segment_sum(src, seg, n):
    out = torch.zeros((n,) + src.shape[1:], dtype=src.dtype)
    return out.index_add_(0, seg, src)
def _pad(x, pw):
    flat = tuple(v for pair in reversed(pw) for v in pair)
    return torch.nn.functional.pad(x, flat)

kernel_name = 'standalone__paged_block_table_kv_radixattention__decode'

def setup_inputs():

    _w = (lambda a: (lambda t: t.to(torch.bfloat16) if t.is_floating_point() else t)(torch.as_tensor(a)))
    B, H, Hkv, Dh = 4, 32, 32, 128
    Lk = 8192
    bs = 16
    nb = max(2, Lk // bs)
    P = max(1, nb // 2)
    n_phys = P + B * (nb - P)
    shared = torch.arange(P, dtype=torch.int64)
    priv = P + torch.arange(B * (nb - P), dtype=torch.int64).reshape(B, nb - P)
    bt = torch.cat([torch.tile(shared[None, :], (B, 1)), priv], dim=1)
    ctx = nb * bs - (torch.arange(1, B + 1, dtype=torch.int64) * 2654435761) % max(1, (nb * bs - P * bs) // 2)
    return {
        "q": _w((lambda *s: torch.randn(*s, dtype=torch.bfloat16) * 0.8)(B, H, Dh)),
        "k_cache": _w((lambda *s: torch.randn(*s, dtype=torch.bfloat16) * 0.8)(n_phys, bs, Hkv, Dh)),
        "v_cache": _w((lambda *s: torch.randn(*s, dtype=torch.bfloat16) * 0.05)(n_phys, bs, Hkv, Dh)),
        "block_table": _w(bt.to(torch.int64)),
        "ctx_lens": _w(torch.as_tensor(ctx).to(torch.int64)),
    }

def reference(q, k_cache, v_cache, block_table, ctx_lens):
    B, H, Dh = q.shape
    n_phys, bs, Hkv, _ = k_cache.shape
    nb = block_table.shape[1]
    Lk = nb * bs
    rep = H // Hkv
    k = k_cache[block_table].reshape(B, Lk, Hkv, Dh)
    v = v_cache[block_table].reshape(B, Lk, Hkv, Dh)
    k = (lambda x, n, axis: torch.repeat_interleave(x, n, dim=axis))(k, rep, axis=2)
    v = (lambda x, n, axis: torch.repeat_interleave(x, n, dim=axis))(v, rep, axis=2)
    scores = torch.einsum("bhd,bkhd->bhk", q, k) * (Dh ** -0.5)
    pos = torch.arange(Lk)
    valid = pos[None, :] < ctx_lens[:, None]
    scores = torch.where(valid[:, None, :], scores, -1e9)
    p = _softmax(scores, axis=-1)
    return torch.einsum("bhk,bkhd->bhd", p, v)
```

```asm
; @launch grid=(256,1,1) block=(256,1,1) lds=24832
.amdgcn_target "amdgcn-amd-amdhsa--gfx950"
.text
.globl standalone__paged_block_table_kv_radixattention__decode_kernel
.p2align 8
.type standalone__paged_block_table_kv_radixattention__decode_kernel,@function
standalone__paged_block_table_kv_radixattention__decode_kernel:
    s_cmp_ge_u32 s2, 256
    s_cbranch_scc1 L_end
    s_load_dwordx16 s[4:19], s[0:1], 0
    v_and_b32 v1, 63, v0
    v_lshrrev_b32 v2, 6, v0
    v_lshlrev_b32 v3, 3, v0
    v_readfirstlane_b32 s3, v2
    s_lshr_b32 s44, s2, 3
    s_and_b32 s44, s44, 7
    s_lshr_b32 s45, s2, 6
    s_lshl_b32 s45, s45, 3
    s_and_b32 s46, s2, 7
    s_or_b32 s45, s45, s46
    s_lshl_b32 s44, s44, 2
    s_add_u32 s44, s44, s3
    s_movk_i32 s47, 0x1000
    v_bfe_u32 v4, v1, 2, 2
    v_and_b32 v5, 3, v1
    v_lshrrev_b32 v15, 4, v1
    v_lshlrev_b32 v6, 13, v4
    v_lshl_add_u32 v6, v15, 6, v6
    v_lshl_add_u32 v6, v5, 4, v6
    v_and_b32 v7, 15, v1
    v_lshlrev_b32 v7, 4, v7
    v_lshl_add_u32 v7, v15, 13, v7
    v_mov_b32 v22, v7
    v_mov_b32 v23, v3
    v_mov_b32 v2, v6
    v_add_u32 v3, 32768, v2
    v_add_u32 v4, 65536, v2
    v_add_u32 v5, 98304, v2
    v_mov_b32 v6, v22
    v_add_u32 v7, 32768, v22
    v_add_u32 v8, 65536, v22
    v_add_u32 v9, 98304, v22
    v_mov_b32 v108, 1073741824
    v_cmp_eq_u32 vcc, 0, v1
    s_mov_b32 s30, 8192
    s_mov_b32 s31, 0x00020000
    v_cndmask_b32 v108, v108, 0, vcc
    s_mov_b32 s34, 32768
    s_mov_b32 s35, 0x00020000
    s_mov_b32 s22, 167772160
    s_mov_b32 s23, 0x00020000
    s_mov_b32 s26, 167772160
    s_mov_b32 s27, 0x00020000
    s_waitcnt lgkmcnt(0)
    s_mul_i32 s48, s45, 8
    s_load_dwordx4 s[36:39], s[12:13], 0
    s_load_dwordx4 s[72:75], s[10:11], s48
    s_lshr_b32 s48, s6, 8
    s_andn2_b32 s48, 31, s48
    s_lshr_b32 s48, s48, 2
    s_lshr_b32 s49, s8, 8
    s_andn2_b32 s49, 31, s49
    s_lshr_b32 s49, s49, 2
    s_cmp_eq_u32 s48, s49
    s_cselect_b32 s0, s48, 8
    s_lshr_b32 s50, s44, 2
    s_cmp_gt_u32 s50, s0
    s_cselect_b32 s49, 1, 0
    s_sub_u32 s1, s50, s49
    s_add_u32 s49, s1, 32
    s_mul_i32 s49, s49, 8
    s_load_dwordx4 s[84:87], s[10:11], s49
    s_mov_b32 s28, s10
    s_and_b32 s29, s11, 0xffff
    buffer_load_dwordx2 v[36:37], v23, s[28:31], 0 offen
    buffer_load_dwordx2 v[38:39], v23, s[28:31], 0 offen offset:2048
    buffer_load_dwordx2 v[40:41], v23, s[28:31], s47 offen
    buffer_load_dwordx2 v[42:43], v23, s[28:31], s47 offen offset:2048
    s_mov_b32 s32, s4
    s_and_b32 s33, s5, 0xffff
    s_lshl_b32 s52, s44, 8
    s_and_b32 s51, s44, 3
    s_lshl_b32 s53, s0, 2
    s_add_u32 s53, s53, s51
    s_lshl_b32 s53, s53, 8
    buffer_load_dwordx4 v[10:13], v2, s[32:35], s52 offen
    buffer_load_dwordx4 v[104:107], v2, s[32:35], s53 offen
    s_mov_b32 s20, s6
    s_and_b32 s21, s7, 0xffff
    s_mov_b32 s24, s8
    s_and_b32 s25, s9, 0xffff
    v_mov_b32 v16, 0xf149f2ca
    v_mov_b32 v23, 0x7149f2ca
    v_mov_b32 v17, 0
    v_lshlrev_b32 v35, 4, v15
    s_mul_i32 s48, s44, 4352
    s_add_u32 s48, s48, 5242880
    s_waitcnt lgkmcnt(0)
    s_mov_b32 s62, 0
    s_cmp_le_i32 s36, 0
    s_cselect_b32 s40, 0x2000, s36
    s_cselect_b32 s49, 15, 0
    s_min_i32 s40, s40, 0x2000
    s_or_b32 s62, s62, s49
    s_cmp_le_i32 s37, 0
    s_cselect_b32 s41, 0x2000, s37
    s_cselect_b32 s49, 240, 0
    s_min_i32 s41, s41, 0x2000
    s_or_b32 s62, s62, s49
    s_cmp_le_i32 s38, 0
    s_cselect_b32 s42, 0x2000, s38
    s_cselect_b32 s49, 3840, 0
    s_min_i32 s42, s42, 0x2000
    s_or_b32 s62, s62, s49
    s_cmp_le_i32 s39, 0
    s_cselect_b32 s43, 0x2000, s39
    s_cselect_b32 s49, 61440, 0
    s_min_i32 s43, s43, 0x2000
    s_or_b32 s62, s62, s49
    s_cmp_ge_i32 s40, 5120
    s_cselect_b32 s4, 1, 0
    s_cmp_lt_u32 s0, 8
    s_cselect_b32 s4, s4, 0
    s_cmp_eq_u32 s45, 31
    s_cselect_b32 s49, 5, 1
    s_cmp_eq_u32 s50, s0
    s_cselect_b32 s49, 3, s49
    s_cmp_lg_u32 s4, 0
    s_cselect_b32 s4, s49, 0
    s_mul_i32 s6, s45, 16
    s_mov_b32 s5, s52
    s_bitcmp1_b32 s4, 2
    s_cbranch_scc0 L_nothelpa
    s_mov_b32 s5, s53
    s_add_u32 s6, s1, 32
    s_mul_i32 s6, s6, 16
    s_mov_b64 s[72:73], s[84:85]
    s_mov_b64 s[74:75], s[86:87]
L_nothelpa:
    s_cmp_ge_i32 s40, 1024
    s_cselect_b32 s76, 1, 0
    s_lshl_b32 s72, s72, 17
    s_add_u32 s72, s72, s5
    s_cmp_lg_u32 s76, 0
    s_cselect_b32 s72, s72, 1073741824
    s_lshl_b32 s73, s73, 17
    s_add_u32 s73, s73, s5
    s_cmp_lg_u32 s76, 0
    s_cselect_b32 s73, s73, 1073741824
    s_mov_b32 s32, s18
    s_and_b32 s33, s19, 0xffff
    s_mov_b32 s34, 5414912
    s_or_b32 s49, s45, s44
    s_cmp_lg_u32 s49, 0
    s_cbranch_scc1 L_noinita
    v_mov_b32 v24, 0
    v_mul_u32_u24 v25, 4352, v1
    s_mov_b32 exec_hi, 0
    s_mov_b32 s49, 5242880
    buffer_store_dword v24, v25, s[32:35], s49 offen sc0 sc1
    s_mov_b32 exec_hi, -1
L_noinita:
    s_mov_b32 s49, 1073741824
    buffer_load_dword v100, v108, s[32:35], s49 offen
    buffer_load_dwordx4 v[112:115], v2, s[20:23], s72 offen nt
    buffer_load_dwordx4 v[116:119], v3, s[20:23], s72 offen nt
    buffer_load_dwordx4 v[120:123], v4, s[20:23], s72 offen nt
    buffer_load_dwordx4 v[124:127], v5, s[20:23], s72 offen nt
    buffer_load_dwordx4 v[128:131], v6, s[24:27], s72 offen nt
    buffer_load_dwordx4 v[132:135], v7, s[24:27], s72 offen nt
    buffer_load_dwordx4 v[136:139], v8, s[24:27], s72 offen nt
    buffer_load_dwordx4 v[140:143], v9, s[24:27], s72 offen nt
    buffer_load_dword v101, v108, s[32:35], s49 offen
    buffer_load_dwordx4 v[144:147], v2, s[20:23], s73 offen nt
    buffer_load_dwordx4 v[148:151], v3, s[20:23], s73 offen nt
    buffer_load_dwordx4 v[152:155], v4, s[20:23], s73 offen nt
    buffer_load_dwordx4 v[156:159], v5, s[20:23], s73 offen nt
    buffer_load_dwordx4 v[160:163], v6, s[24:27], s73 offen nt
    buffer_load_dwordx4 v[164:167], v7, s[24:27], s73 offen nt
    buffer_load_dwordx4 v[168:171], v8, s[24:27], s73 offen nt
    buffer_load_dwordx4 v[172:175], v9, s[24:27], s73 offen nt
    s_mov_b32 s50, 0x3e0293ee
    s_mov_b32 s51, 0x05040100
    s_mov_b32 s52, 0x07060302
    s_mul_i32 s62, s62, 0x10001
    s_mov_b32 s63, s62
    s_mov_b32 exec_lo, 0xf000f
    s_mov_b32 exec_hi, 0xf000f
    v_mov_b32 v14, s40
    s_mov_b32 exec_lo, 0xf000f0
    s_mov_b32 exec_hi, 0xf000f0
    v_mov_b32 v14, s41
    s_mov_b32 exec_lo, 0xf000f00
    s_mov_b32 exec_hi, 0xf000f00
    v_mov_b32 v14, s42
    s_mov_b32 exec_lo, 0xf000f000
    s_mov_b32 exec_hi, 0xf000f000
    v_mov_b32 v14, s43
    s_mov_b64 exec, -1
    v_mov_b32 v52, 0x00f00000
    v_mov_b32 v53, 0x0f000000
    v_mov_b32 v54, 0xf0000000
    v_lshlrev_b32 v44, 5, v0
    v_add_u32 v45, 16, v44
    s_waitcnt vmcnt(18)
    v_cndmask_b32 v10, v10, 0, s[62:63]
    v_cndmask_b32 v104, v104, 0, s[62:63]
    v_cndmask_b32 v11, v11, 0, s[62:63]
    v_cndmask_b32 v105, v105, 0, s[62:63]
    v_cndmask_b32 v12, v12, 0, s[62:63]
    v_cndmask_b32 v106, v106, 0, s[62:63]
    v_cndmask_b32 v13, v13, 0, s[62:63]
    v_cndmask_b32 v107, v107, 0, s[62:63]
    s_bitcmp1_b32 s4, 2
    s_cbranch_scc0 L_noswapa
    v_swap_b32 v10, v104
    v_swap_b32 v11, v105
    v_swap_b32 v12, v106
    v_swap_b32 v13, v107
L_noswapa:
    s_mov_b32 s55, s76
    v_add_u32 v46, 16, v44
    v_cmp_gt_i32 s[82:83], s40, v44
    v_cmp_gt_i32 s[84:85], s41, v44
    v_cmp_gt_i32 s[86:87], s42, v44
    v_cmp_gt_i32 s[88:89], s43, v44
    v_cmp_lt_i32 s[66:67], s40, v46
    v_cmp_lt_i32 s[68:69], s41, v46
    v_cmp_lt_i32 s[70:71], s42, v46
    v_cmp_lt_i32 s[72:73], s43, v46
    s_and_b64 s[66:67], s[66:67], s[82:83]
    s_and_b64 s[68:69], s[68:69], s[84:85]
    s_and_b64 s[70:71], s[70:71], s[86:87]
    s_and_b64 s[72:73], s[72:73], s[88:89]
    s_or_b64 s[62:63], s[66:67], s[68:69]
    s_or_b64 vcc, s[70:71], s[72:73]
    s_or_b64 vcc, vcc, s[62:63]
    v_cndmask_b32 v48, -1, v36, s[82:83]
    v_cndmask_b32 v49, -2, v38, s[84:85]
    v_cndmask_b32 v50, -3, v40, s[86:87]
    v_cndmask_b32 v51, -4, v42, s[88:89]
    v_mov_b32 v47, 0x8000
    v_cndmask_b32 v47, 0, v47, vcc
    v_or_b32 v47, v47, v44
    v_cmp_eq_u32 s[90:91], v48, v49
    v_cmp_eq_u32 s[92:93], v48, v50
    v_cmp_eq_u32 s[94:95], v48, v51
    v_cmp_eq_u32 s[96:97], v49, v50
    v_cmp_eq_u32 s[98:99], v49, v51
    v_cmp_eq_u32 s[100:101], v50, v51
    v_lshlrev_b32 v80, 17, v36
    v_lshlrev_b32 v82, 17, v38
    v_lshlrev_b32 v84, 17, v40
    v_lshlrev_b32 v86, 17, v42
    s_mov_b64 s[66:67], s[82:83]
    s_andn2_b64 s[68:69], s[84:85], s[90:91]
    s_or_b64 vcc, s[92:93], s[96:97]
    s_andn2_b64 s[70:71], s[86:87], vcc
    s_or_b64 vcc, s[94:95], s[98:99]
    s_or_b64 vcc, vcc, s[100:101]
    s_andn2_b64 s[72:73], s[88:89], vcc
    v_cndmask_b32 v56, 0, v52, s[90:91]
    v_cndmask_b32 v57, 0, v53, s[92:93]
    v_cndmask_b32 v58, 0, v54, s[94:95]
    v_cndmask_b32 v59, 0, v53, s[96:97]
    v_cndmask_b32 v60, 0, v54, s[98:99]
    v_cndmask_b32 v61, 0, v54, s[100:101]
    v_or3_b32 v81, v47, v56, v57
    v_or_b32 v81, v81, v58
    v_or_b32 v81, 0xf0000, v81
    v_or3_b32 v83, v47, v59, v60
    v_or_b32 v83, v83, v52
    v_or3_b32 v85, v47, v61, v53
    v_or_b32 v87, v47, v54
    v_cndmask_b32 v56, 0, 1, s[66:67]
    v_cndmask_b32 v57, 0, 1, s[68:69]
    v_cndmask_b32 v58, 0, 1, s[70:71]
    v_cndmask_b32 v59, 0, 1, s[72:73]
    v_lshl_or_b32 v62, v57, 8, v56
    v_lshl_or_b32 v62, v58, 16, v62
    v_lshl_or_b32 v62, v59, 24, v62
    v_add_u32 v46, 16, v45
    v_cmp_gt_i32 s[82:83], s40, v45
    v_cmp_gt_i32 s[84:85], s41, v45
    v_cmp_gt_i32 s[86:87], s42, v45
    v_cmp_gt_i32 s[88:89], s43, v45
    v_cmp_lt_i32 s[74:75], s40, v46
    v_cmp_lt_i32 s[76:77], s41, v46
    v_cmp_lt_i32 s[78:79], s42, v46
    v_cmp_lt_i32 s[80:81], s43, v46
    s_and_b64 s[74:75], s[74:75], s[82:83]
    s_and_b64 s[76:77], s[76:77], s[84:85]
    s_and_b64 s[78:79], s[78:79], s[86:87]
    s_and_b64 s[80:81], s[80:81], s[88:89]
    s_or_b64 s[62:63], s[74:75], s[76:77]
    s_or_b64 vcc, s[78:79], s[80:81]
    s_or_b64 vcc, vcc, s[62:63]
    v_cndmask_b32 v48, -1, v37, s[82:83]
    v_cndmask_b32 v49, -2, v39, s[84:85]
    v_cndmask_b32 v50, -3, v41, s[86:87]
    v_cndmask_b32 v51, -4, v43, s[88:89]
    v_mov_b32 v47, 0x8000
    v_cndmask_b32 v47, 0, v47, vcc
    v_or_b32 v47, v47, v45
    v_cmp_eq_u32 s[90:91], v48, v49
    v_cmp_eq_u32 s[92:93], v48, v50
    v_cmp_eq_u32 s[94:95], v48, v51
    v_cmp_eq_u32 s[96:97], v49, v50
    v_cmp_eq_u32 s[98:99], v49, v51
    v_cmp_eq_u32 s[100:101], v50, v51
    v_lshlrev_b32 v88, 17, v37
    v_lshlrev_b32 v90, 17, v39
    v_lshlrev_b32 v92, 17, v41
    v_lshlrev_b32 v94, 17, v43
    s_mov_b64 s[74:75], s[82:83]
    s_andn2_b64 s[76:77], s[84:85], s[90:91]
    s_or_b64 vcc, s[92:93], s[96:97]
    s_andn2_b64 s[78:79], s[86:87], vcc
    s_or_b64 vcc, s[94:95], s[98:99]
    s_or_b64 vcc, vcc, s[100:101]
    s_andn2_b64 s[80:81], s[88:89], vcc
    v_cndmask_b32 v56, 0, v52, s[90:91]
    v_cndmask_b32 v57, 0, v53, s[92:93]
    v_cndmask_b32 v58, 0, v54, s[94:95]
    v_cndmask_b32 v59, 0, v53, s[96:97]
    v_cndmask_b32 v60, 0, v54, s[98:99]
    v_cndmask_b32 v61, 0, v54, s[100:101]
    v_or3_b32 v89, v47, v56, v57
    v_or_b32 v89, v89, v58
    v_or_b32 v89, 0xf0000, v89
    v_or3_b32 v91, v47, v59, v60
    v_or_b32 v91, v91, v52
    v_or3_b32 v93, v47, v61, v53
    v_or_b32 v95, v47, v54
    v_cndmask_b32 v56, 0, 1, s[74:75]
    v_cndmask_b32 v57, 0, 1, s[76:77]
    v_cndmask_b32 v58, 0, 1, s[78:79]
    v_cndmask_b32 v59, 0, 1, s[80:81]
    v_lshl_or_b32 v63, v57, 8, v56
    v_lshl_or_b32 v63, v58, 16, v63
    v_lshl_or_b32 v63, v59, 24, v63
    v_add_u32 v64, v62, v63
    v_mov_b32 v65, v64
    s_nop 1
    v_add_u32_dpp v64, v64, v64 row_shr:1 row_mask:0xf bank_mask:0xf bound_ctrl:0
    s_nop 1
    v_add_u32_dpp v64, v64, v64 row_shr:2 row_mask:0xf bank_mask:0xf bound_ctrl:0
    s_nop 1
    v_add_u32_dpp v64, v64, v64 row_shr:4 row_mask:0xf bank_mask:0xf bound_ctrl:0
    s_nop 1
    v_add_u32_dpp v64, v64, v64 row_shr:8 row_mask:0xf bank_mask:0xf bound_ctrl:0
    s_nop 1
    v_add_u32_dpp v64, v64, v64 row_bcast:15 row_mask:0xa bank_mask:0xf
    s_nop 1
    v_add_u32_dpp v64, v64, v64 row_bcast:31 row_mask:0xc bank_mask:0xf
    s_nop 1
    v_readlane_b32 s49, v64, 63
    v_sub_u32 v65, v64, v65
    v_add_u32 v66, v65, v62
    s_lshl_b32 s46, s3, 2
    s_add_u32 s46, s46, 16400
    v_mov_b32 v67, s49
    v_mov_b32 v72, s46
    ds_write_b32 v72, v67
    v_and_b32 v72, 3, v1
    v_lshlrev_b32 v72, 2, v72
    v_bfe_u32 v68, v1, 2, 2
    v_lshlrev_b32 v68, 3, v68
    s_waitcnt lgkmcnt(0)
    s_barrier
    ds_read_b32 v67, v72 offset:16400
    s_waitcnt lgkmcnt(0)
    v_bfe_u32 v69, v67, v68, 8
    v_mov_b32 v70, v69
    s_nop 1
    v_add_u32_dpp v70, v70, v70 row_shr:1 row_mask:0xf bank_mask:0xf bound_ctrl:0
    s_nop 1
    v_add_u32_dpp v70, v70, v70 row_shr:2 row_mask:0xf bank_mask:0xf bound_ctrl:0
    s_nop 1
    v_add_u32_dpp v70, v70, v70 row_shr:4 row_mask:0xf bank_mask:0xf bound_ctrl:0
    s_nop 1
    v_add_u32_dpp v70, v70, v70 row_shr:8 row_mask:0xf bank_mask:0xf bound_ctrl:0
    v_sub_u32 v69, v70, v69
    v_readlane_b32 s47, v70, 15
    s_add_u32 s49, s3, 0
    v_readlane_b32 s36, v69, s49
    s_add_u32 s49, s3, 4
    v_readlane_b32 s37, v69, s49
    s_add_u32 s49, s3, 8
    v_readlane_b32 s38, v69, s49
    s_add_u32 s49, s3, 12
    v_readlane_b32 s39, v69, s49
    s_lshl_b32 s47, s47, 3
    v_mov_b32 v74, 1073741824
    v_mov_b32 v75, 0
    v_mov_b32 v73, s47
    ds_write_b64 v73, v[74:75]
    v_bfe_u32 v56, v65, 0, 8
    v_add_lshl_u32 v56, v56, s36, 3
    v_bfe_u32 v57, v65, 8, 8
    v_add_lshl_u32 v57, v57, s37, 3
    v_bfe_u32 v58, v65, 16, 8
    v_add_lshl_u32 v58, v58, s38, 3
    v_bfe_u32 v59, v65, 24, 8
    v_add_lshl_u32 v59, v59, s39, 3
    s_mov_b64 exec, s[66:67]
    ds_write_b64 v56, v[80:81]
    s_mov_b64 exec, s[68:69]
    ds_write_b64 v57, v[82:83]
    s_mov_b64 exec, s[70:71]
    ds_write_b64 v58, v[84:85]
    s_mov_b64 exec, s[72:73]
    ds_write_b64 v59, v[86:87]
    s_mov_b64 exec, -1
    v_bfe_u32 v56, v66, 0, 8
    v_add_lshl_u32 v56, v56, s36, 3
    v_bfe_u32 v57, v66, 8, 8
    v_add_lshl_u32 v57, v57, s37, 3
    v_bfe_u32 v58, v66, 16, 8
    v_add_lshl_u32 v58, v58, s38, 3
    v_bfe_u32 v59, v66, 24, 8
    v_add_lshl_u32 v59, v59, s39, 3
    s_mov_b64 exec, s[74:75]
    ds_write_b64 v56, v[88:89]
    s_mov_b64 exec, s[76:77]
    ds_write_b64 v57, v[90:91]
    s_mov_b64 exec, s[78:79]
    ds_write_b64 v58, v[92:93]
    s_mov_b64 exec, s[80:81]
    ds_write_b64 v59, v[94:95]
    s_mov_b64 exec, -1
    s_mov_b32 s67, s48
    s_mov_b32 s7, 2147483647
    s_mov_b32 s8, 2147483647
    s_mov_b32 s11, 0
    s_bitcmp1_b32 s4, 0
    s_cbranch_scc0 L_nohma
    s_lshr_b32 s70, s47, 3
    s_mul_i32 s71, s70, 18
    s_lshr_b32 s71, s71, 11
    s_max_u32 s71, s71, 2
    s_sub_u32 s72, s71, 2
    s_mul_i32 s73, s72, 7
    s_sub_u32 s74, s70, 78
    s_sub_u32 s74, s74, s73
    s_mul_i32 s74, s74, 23
    s_lshr_b32 s74, s74, 10
    s_max_u32 s74, s74, 2
    s_max_u32 s74, s74, s72
    s_add_u32 s78, s72, 1
    s_max_u32 s74, s74, s78
    s_lshl_b32 s75, s74, 5
    s_add_u32 s75, s75, 78
    s_sub_u32 s76, s70, 62
    s_mul_i32 s76, s76, 23
    s_lshr_b32 s76, s76, 10
    s_max_u32 s76, s76, s71
    s_bitcmp1_b32 s4, 1
    s_cbranch_scc0 L_hmnorma
    s_mul_i32 s77, s45, s74
    s_add_u32 s77, s77, 78
    s_mov_b32 s49, s74
    s_add_u32 s75, s75, s73
    s_mov_b32 s11, 1
    s_branch L_hmseta
L_hmnorma:
    s_mul_i32 s77, s45, s76
    s_add_u32 s77, s77, 62
    s_mov_b32 s49, s76
    s_bitcmp1_b32 s4, 2
    s_cbranch_scc0 L_hmnorm2a
    s_lshl_b32 s9, s77, 3
    s_mul_i32 s77, s1, s72
    s_add_u32 s77, s77, s75
    s_mov_b32 s7, s72
    s_mov_b32 s8, s71
    s_and_b32 s78, s44, 3
    s_lshl_b32 s10, s0, 2
    s_add_u32 s10, s10, s78
    s_mul_i32 s10, s10, 40
    s_add_u32 s10, s10, s1
    s_add_u32 s10, s10, 32
    s_mul_i32 s10, s10, 2048
L_hmnorm2a:
    s_lshl_b32 s75, s76, 5
    s_add_u32 s75, s75, 64
    s_sub_u32 s75, s75, s71
L_hmseta:
    s_lshr_b32 s79, s47, 3
    s_mul_i32 s79, s79, 5
    s_lshr_b32 s79, s79, 10
    s_lshr_b32 s78, s45, 1
    s_add_u32 s78, s78, s75
    s_lshl_b32 s38, s78, 3
    s_lshl_b32 s78, s79, 4
    s_add_u32 s75, s75, s78
    s_sub_u32 s36, s49, s72
    s_sub_u32 s36, s36, 1
    s_movk_i32 s37, 256
    s_bitcmp1_b32 s45, 0
    s_cselect_b32 s36, 2147483647, s36
    s_cselect_b32 s79, 0, s79
    s_add_u32 s49, s49, s79
    s_lshl_b32 s66, s75, 3
    s_min_u32 s66, s66, s47
    s_lshl_b32 s46, s77, 3
    s_mov_b32 s7, s72
    s_mul_i32 s78, s72, 31
    s_add_u32 s78, s78, 62
    s_add_u32 s78, s78, s45
    s_add_u32 s77, s45, 62
    s_movk_i32 s13, 248
    s_bitcmp1_b32 s4, 2
    s_cbranch_scc0 L_ilv1a
    s_add_u32 s77, s1, 110
    s_movk_i32 s13, 312
L_ilv1a:
    s_bitcmp1_b32 s4, 1
    s_cbranch_scc0 L_ilv2a
    s_add_u32 s77, s45, 78
    s_mul_i32 s78, s72, 39
    s_add_u32 s78, s78, s77
    s_movk_i32 s13, 312
L_ilv2a:
    s_lshl_b32 s46, s77, 3
    s_lshl_b32 s9, s78, 3
L_schedreta:
    s_mov_b32 s62, 0
    s_mov_b32 s63, 0
    s_mov_b32 s95, 0
    s_mov_b32 s69, 128
    s_mov_b32 s28, s16
    s_and_b32 s29, s17, 0xffff
    s_mov_b32 s30, 256
    v_mov_b32 v68, 0
    v_mov_b32 v69, 0
    v_mov_b32 v70, 0
    v_mov_b32 v71, 0
    v_mov_b32 v72, 0
    v_mov_b32 v73, 0
    v_mov_b32 v74, 0
    v_mov_b32 v75, 0
    v_mov_b32 v76, 0
    v_mov_b32 v77, 0
    v_mov_b32 v78, 0
    v_mov_b32 v79, 0
    v_mov_b32 v80, 0
    v_mov_b32 v81, 0
    v_mov_b32 v82, 0
    v_mov_b32 v83, 0
    v_mov_b32 v84, 0
    v_mov_b32 v85, 0
    v_mov_b32 v86, 0
    v_mov_b32 v87, 0
    v_mov_b32 v88, 0
    v_mov_b32 v89, 0
    v_mov_b32 v90, 0
    v_mov_b32 v91, 0
    v_mov_b32 v92, 0
    v_mov_b32 v93, 0
    v_mov_b32 v94, 0
    v_mov_b32 v95, 0
    v_mov_b32 v96, 0
    v_mov_b32 v97, 0
    v_mov_b32 v98, 0
    v_mov_b32 v99, 0
    s_waitcnt lgkmcnt(0)
    s_barrier
    s_or_b32 s72, s45, s44
    s_cmp_lg_u32 s72, 0
    s_cbranch_scc1 L_nopuba
    s_memrealtime s[72:73]
    s_waitcnt vmcnt(18) lgkmcnt(0)
    s_or_b32 s62, s72, 1
    v_mov_b32 v22, s62
    buffer_store_dword v22, v108, s[28:31], s69 offen sc0 sc1
L_nopuba:
    s_cmp_lg_u32 s55, 0
    s_cbranch_scc0 L_filla
    v_mov_b32 v22, s6
    ds_read_b64 v[36:37], v22 offset:0
    v_mov_b32 v22, s6
    ds_read_b64 v[38:39], v22 offset:8
    s_waitcnt lgkmcnt(0)
    v_readfirstlane_b32 s56, v37
    v_readfirstlane_b32 s57, v39
L_goa:
    s_sub_u32 s7, s7, 1
    s_cbranch_scc1 L_swf1a
L_swfret1a:
    s_min_u32 s48, s46, s47
    s_add_u32 s46, s46, s13
    s_sub_u32 s49, s49, 1
L_loopa:
    s_sub_u32 s8, s8, 1
    s_cbranch_scc1 L_sw0a
L_swret0a:
    v_mov_b32 v22, s48
    s_mov_b32 s53, s56
    ds_read_b64 v[20:21], v22
    s_cmp_eq_u32 s53, 0
    s_cbranch_scc1 L_done
    s_cmp_lt_i32 s49, 2
    s_cbranch_scc1 L_xdyn0a
    s_cmp_eq_u32 s62, 0
    s_cselect_b32 s68, s69, 1073741824
    buffer_load_dword v100, v108, s[28:31], s68 offen sc0 sc1
L_xret0a:
    s_waitcnt vmcnt(14)
    v_mfma_f32_16x16x32_bf16 v[36:39], v[112:115], v[10:13], 0
    v_mfma_f32_16x16x32_bf16 v[40:43], v[116:119], v[10:13], 0
    v_mfma_f32_16x16x32_bf16 v[44:47], v[120:123], v[10:13], 0
    v_mfma_f32_16x16x32_bf16 v[48:51], v[124:127], v[10:13], 0
    s_pack_hh_b32_b16 s64, s53, s53
    s_mov_b32 s65, s64
    v_cndmask_b32 v18, v23, v16, s[64:65]
    s_waitcnt lgkmcnt(0)
    v_readfirstlane_b32 s54, v20
    v_readfirstlane_b32 s56, v21
    s_add_u32 s54, s54, s5
    v_mov_b32_dpp v24, v36 quad_perm:[0,0,0,0] row_mask:0xf bank_mask:0xf
    v_mov_b32_dpp v25, v40 quad_perm:[0,0,0,0] row_mask:0xf bank_mask:0xf
    v_mov_b32_dpp v26, v44 quad_perm:[0,0,0,0] row_mask:0xf bank_mask:0xf
    v_mov_b32_dpp v27, v48 quad_perm:[0,0,0,0] row_mask:0xf bank_mask:0xf
    buffer_load_dwordx4 v[112:115], v2, s[20:23], s54 offen nt
    buffer_load_dwordx4 v[116:119], v3, s[20:23], s54 offen nt
    buffer_load_dwordx4 v[120:123], v4, s[20:23], s54 offen nt
    buffer_load_dwordx4 v[124:127], v5, s[20:23], s54 offen nt
    v_add_f32_dpp v24, v37, v24 quad_perm:[1,1,1,1] row_mask:0xf bank_mask:0xf
    v_add_f32_dpp v25, v41, v25 quad_perm:[1,1,1,1] row_mask:0xf bank_mask:0xf
    v_add_f32_dpp v26, v45, v26 quad_perm:[1,1,1,1] row_mask:0xf bank_mask:0xf
    v_add_f32_dpp v27, v49, v27 quad_perm:[1,1,1,1] row_mask:0xf bank_mask:0xf
    v_add_f32_dpp v24, v38, v24 quad_perm:[2,2,2,2] row_mask:0xf bank_mask:0xf
    v_add_f32_dpp v25, v42, v25 quad_perm:[2,2,2,2] row_mask:0xf bank_mask:0xf
    v_add_f32_dpp v26, v46, v26 quad_perm:[2,2,2,2] row_mask:0xf bank_mask:0xf
    v_add_f32_dpp v27, v50, v27 quad_perm:[2,2,2,2] row_mask:0xf bank_mask:0xf
    v_add_f32_dpp v24, v39, v24 quad_perm:[3,3,3,3] row_mask:0xf bank_mask:0xf
    v_add_f32_dpp v25, v43, v25 quad_perm:[3,3,3,3] row_mask:0xf bank_mask:0xf
    v_add_f32_dpp v26, v47, v26 quad_perm:[3,3,3,3] row_mask:0xf bank_mask:0xf
    v_add_f32_dpp v27, v51, v27 quad_perm:[3,3,3,3] row_mask:0xf bank_mask:0xf
L_redo0a:
    v_fma_f32 v28, v24, s50, -v18
    v_fma_f32 v29, v25, s50, -v18
    v_fma_f32 v30, v26, s50, -v18
    v_fma_f32 v31, v27, s50, -v18
    s_bitcmp1_b32 s53, 15
    s_cbranch_scc1 L_part0a
L_partret0a:
    v_max3_f32 v19, v28, v29, v30
    v_max_f32 v19, v19, v31
    v_cmp_lt_f32 vcc, 0x41000000, v19
    s_cbranch_vccnz L_slow0a
    v_exp_f32 v28, v28
    v_exp_f32 v29, v29
    v_exp_f32 v30, v30
    v_exp_f32 v31, v31
    v_add_f32 v19, v28, v29
    v_cvt_pk_bf16_f32 v32, v28, v29
    v_add_f32 v34, v30, v31
    v_cvt_pk_bf16_f32 v33, v30, v31
    v_add_f32 v17, v17, v19
    v_add_f32 v17, v17, v34
    s_waitcnt vmcnt(13)
    v_readfirstlane_b32 s70, v101
    v_perm_b32 v52, v132, v128, s51
    v_perm_b32 v53, v140, v136, s51
    v_perm_b32 v54, v132, v128, s52
    v_perm_b32 v55, v140, v136, s52
    v_perm_b32 v56, v133, v129, s51
    v_perm_b32 v57, v141, v137, s51
    v_perm_b32 v58, v133, v129, s52
    v_perm_b32 v59, v141, v137, s52
    v_perm_b32 v60, v134, v130, s51
    v_perm_b32 v61, v142, v138, s51
    v_perm_b32 v62, v134, v130, s52
    v_perm_b32 v63, v142, v138, s52
    v_perm_b32 v64, v135, v131, s51
    v_perm_b32 v65, v143, v139, s51
    v_perm_b32 v66, v135, v131, s52
    v_perm_b32 v67, v143, v139, s52
    buffer_load_dwordx4 v[128:131], v6, s[24:27], s54 offen nt
    buffer_load_dwordx4 v[132:135], v7, s[24:27], s54 offen nt
    buffer_load_dwordx4 v[136:139], v8, s[24:27], s54 offen nt
    buffer_load_dwordx4 v[140:143], v9, s[24:27], s54 offen nt
    v_mfma_f32_16x16x16_bf16 v[68:71], v[32:33], v[52:53], v[68:71]
    v_mfma_f32_16x16x16_bf16 v[72:75], v[32:33], v[54:55], v[72:75]
    v_mfma_f32_16x16x16_bf16 v[76:79], v[32:33], v[56:57], v[76:79]
    v_mfma_f32_16x16x16_bf16 v[80:83], v[32:33], v[58:59], v[80:83]
    v_mfma_f32_16x16x16_bf16 v[84:87], v[32:33], v[60:61], v[84:87]
    v_mfma_f32_16x16x16_bf16 v[88:91], v[32:33], v[62:63], v[88:91]
    v_mfma_f32_16x16x16_bf16 v[92:95], v[32:33], v[64:65], v[92:95]
    v_mfma_f32_16x16x16_bf16 v[96:99], v[32:33], v[66:67], v[96:99]
    s_cmp_gt_i32 s49, 0
    s_cbranch_scc0 L_ndyn0a
    s_max_u32 s62, s62, s70
    s_sub_u32 s7, s7, 1
    s_cbranch_scc1 L_swf4a
L_swfret4a:
    s_min_u32 s48, s46, s47
    s_add_u32 s46, s46, s13
    s_sub_u32 s49, s49, 1
L_nret0a:
    s_sub_u32 s8, s8, 1
    s_cbranch_scc1 L_sw1a
L_swret1a:
    v_mov_b32 v22, s48
    s_mov_b32 s53, s57
    ds_read_b64 v[20:21], v22
    s_cmp_eq_u32 s53, 0
    s_cbranch_scc1 L_done
    s_cmp_lt_i32 s49, 2
    s_cbranch_scc1 L_xdyn1a
    s_cmp_eq_u32 s62, 0
    s_cselect_b32 s68, s69, 1073741824
    buffer_load_dword v101, v108, s[28:31], s68 offen sc0 sc1
L_xret1a:
    s_waitcnt vmcnt(14)
    v_mfma_f32_16x16x32_bf16 v[36:39], v[144:147], v[10:13], 0
    v_mfma_f32_16x16x32_bf16 v[40:43], v[148:151], v[10:13], 0
    v_mfma_f32_16x16x32_bf16 v[44:47], v[152:155], v[10:13], 0
    v_mfma_f32_16x16x32_bf16 v[48:51], v[156:159], v[10:13], 0
    s_pack_hh_b32_b16 s64, s53, s53
    s_mov_b32 s65, s64
    v_cndmask_b32 v18, v23, v16, s[64:65]
    s_waitcnt lgkmcnt(0)
    v_readfirstlane_b32 s54, v20
    v_readfirstlane_b32 s57, v21
    s_add_u32 s54, s54, s5
    v_mov_b32_dpp v24, v36 quad_perm:[0,0,0,0] row_mask:0xf bank_mask:0xf
    v_mov_b32_dpp v25, v40 quad_perm:[0,0,0,0] row_mask:0xf bank_mask:0xf
    v_mov_b32_dpp v26, v44 quad_perm:[0,0,0,0] row_mask:0xf bank_mask:0xf
    v_mov_b32_dpp v27, v48 quad_perm:[0,0,0,0] row_mask:0xf bank_mask:0xf
    buffer_load_dwordx4 v[144:147], v2, s[20:23], s54 offen nt
    buffer_load_dwordx4 v[148:151], v3, s[20:23], s54 offen nt
    buffer_load_dwordx4 v[152:155], v4, s[20:23], s54 offen nt
    buffer_load_dwordx4 v[156:159], v5, s[20:23], s54 offen nt
    v_add_f32_dpp v24, v37, v24 quad_perm:[1,1,1,1] row_mask:0xf bank_mask:0xf
    v_add_f32_dpp v25, v41, v25 quad_perm:[1,1,1,1] row_mask:0xf bank_mask:0xf
    v_add_f32_dpp v26, v45, v26 quad_perm:[1,1,1,1] row_mask:0xf bank_mask:0xf
    v_add_f32_dpp v27, v49, v27 quad_perm:[1,1,1,1] row_mask:0xf bank_mask:0xf
    v_add_f32_dpp v24, v38, v24 quad_perm:[2,2,2,2] row_mask:0xf bank_mask:0xf
    v_add_f32_dpp v25, v42, v25 quad_perm:[2,2,2,2] row_mask:0xf bank_mask:0xf
    v_add_f32_dpp v26, v46, v26 quad_perm:[2,2,2,2] row_mask:0xf bank_mask:0xf
    v_add_f32_dpp v27, v50, v27 quad_perm:[2,2,2,2] row_mask:0xf bank_mask:0xf
    v_add_f32_dpp v24, v39, v24 quad_perm:[3,3,3,3] row_mask:0xf bank_mask:0xf
    v_add_f32_dpp v25, v43, v25 quad_perm:[3,3,3,3] row_mask:0xf bank_mask:0xf
    v_add_f32_dpp v26, v47, v26 quad_perm:[3,3,3,3] row_mask:0xf bank_mask:0xf
    v_add_f32_dpp v27, v51, v27 quad_perm:[3,3,3,3] row_mask:0xf bank_mask:0xf
L_redo1a:
    v_fma_f32 v28, v24, s50, -v18
    v_fma_f32 v29, v25, s50, -v18
    v_fma_f32 v30, v26, s50, -v18
    v_fma_f32 v31, v27, s50, -v18
    s_bitcmp1_b32 s53, 15
    s_cbranch_scc1 L_part1a
L_partret1a:
    v_max3_f32 v19, v28, v29, v30
    v_max_f32 v19, v19, v31
    v_cmp_lt_f32 vcc, 0x41000000, v19
    s_cbranch_vccnz L_slow1a
    v_exp_f32 v28, v28
    v_exp_f32 v29, v29
    v_exp_f32 v30, v30
    v_exp_f32 v31, v31
    v_add_f32 v19, v28, v29
    v_cvt_pk_bf16_f32 v32, v28, v29
    v_add_f32 v34, v30, v31
    v_cvt_pk_bf16_f32 v33, v30, v31
    v_add_f32 v17, v17, v19
    v_add_f32 v17, v17, v34
    s_waitcnt vmcnt(13)
    v_readfirstlane_b32 s70, v100
    v_perm_b32 v52, v164, v160, s51
    v_perm_b32 v53, v172, v168, s51
    v_perm_b32 v54, v164, v160, s52
    v_perm_b32 v55, v172, v168, s52
    v_perm_b32 v56, v165, v161, s51
    v_perm_b32 v57, v173, v169, s51
    v_perm_b32 v58, v165, v161, s52
    v_perm_b32 v59, v173, v169, s52
    v_perm_b32 v60, v166, v162, s51
    v_perm_b32 v61, v174, v170, s51
    v_perm_b32 v62, v166, v162, s52
    v_perm_b32 v63, v174, v170, s52
    v_perm_b32 v64, v167, v163, s51
    v_perm_b32 v65, v175, v171, s51
    v_perm_b32 v66, v167, v163, s52
    v_perm_b32 v67, v175, v171, s52
    buffer_load_dwordx4 v[160:163], v6, s[24:27], s54 offen nt
    buffer_load_dwordx4 v[164:167], v7, s[24:27], s54 offen nt
    buffer_load_dwordx4 v[168:171], v8, s[24:27], s54 offen nt
    buffer_load_dwordx4 v[172:175], v9, s[24:27], s54 offen nt
    v_mfma_f32_16x16x16_bf16 v[68:71], v[32:33], v[52:53], v[68:71]
    v_mfma_f32_16x16x16_bf16 v[72:75], v[32:33], v[54:55], v[72:75]
    v_mfma_f32_16x16x16_bf16 v[76:79], v[32:33], v[56:57], v[76:79]
    v_mfma_f32_16x16x16_bf16 v[80:83], v[32:33], v[58:59], v[80:83]
    v_mfma_f32_16x16x16_bf16 v[84:87], v[32:33], v[60:61], v[84:87]
    v_mfma_f32_16x16x16_bf16 v[88:91], v[32:33], v[62:63], v[88:91]
    v_mfma_f32_16x16x16_bf16 v[92:95], v[32:33], v[64:65], v[92:95]
    v_mfma_f32_16x16x16_bf16 v[96:99], v[32:33], v[66:67], v[96:99]
    s_cmp_gt_i32 s49, 0
    s_cbranch_scc0 L_ndyn1a
    s_max_u32 s62, s62, s70
    s_sub_u32 s7, s7, 1
    s_cbranch_scc1 L_swf5a
L_swfret5a:
    s_min_u32 s48, s46, s47
    s_add_u32 s46, s46, s13
    s_sub_u32 s49, s49, 1
L_nret1a:
    s_branch L_loopa
L_done:
L_epi:
    s_mul_i32 s70, s44, 40
    s_add_u32 s70, s70, s45
    s_mul_i32 s70, s70, 2048
    v_mov_b32 v34, v17
    s_mov_b32 s72, 0x7060500
    s_mov_b32 s73, 0x7060501
    s_mov_b32 s74, 0x7060502
    v_permlane16_swap_b32 v17, v34
    v_mov_b32_dpp v29, v16 row_newbcast:0 row_mask:0x1 bank_mask:0xf
    v_mov_b32_dpp v29, v16 row_newbcast:4 row_mask:0x2 bank_mask:0xf
    v_mov_b32_dpp v29, v16 row_newbcast:8 row_mask:0x4 bank_mask:0xf
    v_mov_b32_dpp v29, v16 row_newbcast:12 row_mask:0x8 bank_mask:0xf
    v_add_f32 v17, v17, v34
    v_mov_b32 v34, v17
    v_lshlrev_b32 v22, 4, v1
    v_and_b32 v32, 3, v1
    v_permlane32_swap_b32 v17, v34
    v_lshlrev_b32 v32, 3, v32
    v_add_f32 v17, v17, v34
    s_cmp_lg_u32 s62, 0
    s_cbranch_scc1 L_havenonce
L_nspin:
    buffer_load_dword v19, v108, s[28:31], s69 offen sc0 sc1
    s_waitcnt vmcnt(0)
    v_readfirstlane_b32 s62, v19
    s_sleep 4
    s_add_u32 s95, s95, 1
    s_cmp_gt_u32 s95, 200000
    s_cselect_b32 s62, 1, s62
    s_cmp_eq_u32 s62, 0
    s_cbranch_scc1 L_nspin
L_havenonce:
    v_mov_b32 v20, s62
    s_nop 0
    v_mov_b32_dpp v28, v17 row_newbcast:0 row_mask:0x1 bank_mask:0xf
    v_mov_b32_dpp v28, v17 row_newbcast:4 row_mask:0x2 bank_mask:0xf
    v_mov_b32_dpp v28, v17 row_newbcast:8 row_mask:0x4 bank_mask:0xf
    v_mov_b32_dpp v28, v17 row_newbcast:12 row_mask:0x8 bank_mask:0xf
    v_rcp_f32 v30, v28
    v_log_f32 v31, v28
    v_cmp_lt_f32 vcc, 0, v28
    s_nop 0
    v_add_f32 v31, v31, v29
    v_cndmask_b32 v30, 0, v30, vcc
    v_lshrrev_b32 v21, v32, v31
    v_mul_f32 v36, v68, v30
    v_mul_f32 v37, v72, v30
    v_mul_f32 v38, v76, v30
    v_mul_f32 v39, v80, v30
    v_perm_b32 v52, v36, v20, s72
    v_perm_b32 v53, v37, v20, s73
    v_perm_b32 v54, v38, v20, s74
    v_perm_b32 v55, v39, v21, s72
    buffer_store_dwordx4 v[52:55], v22, s[32:35], s70 offen offset:0 sc0 sc1
    v_mul_f32 v40, v84, v30
    v_mul_f32 v41, v88, v30
    v_mul_f32 v42, v92, v30
    v_mul_f32 v43, v96, v30
    v_perm_b32 v56, v40, v20, s72
    v_perm_b32 v57, v41, v20, s73
    v_perm_b32 v58, v42, v20, s74
    v_perm_b32 v59, v43, v21, s72
    buffer_store_dwordx4 v[56:59], v22, s[32:35], s70 offen offset:1024 sc0 sc1
    v_lshrrev_b32 v19, 2, v1
    v_mul_u32_u24 v19, 2048, v19
    v_and_b32 v34, 3, v1
    v_lshl_add_u32 v19, v34, 4, v19
    s_mul_i32 s70, s44, 81920
    s_lshl_b32 s71, s45, 6
    s_add_u32 s70, s70, s71
    s_add_u32 s71, s70, 32768
    s_add_u32 s72, s70, 65536
    s_mov_b64 s[76:77], -1
    s_mov_b64 s[78:79], -1
    s_cmp_lg_u32 s11, 0
    s_cselect_b32 s80, 0x0fffffff, 0
    s_mov_b32 s81, 0
    s_mov_b64 s[54:55], s[80:81]
    s_mov_b32 s82, 0x0c0c0400
    s_mov_b32 s83, 0x0c040100
    s_and_b32 s84, s62, 0xffffff
    v_mov_b32 v76, 0
    v_mov_b32 v77, 0
    v_mov_b32 v78, 0
    v_mov_b32 v79, 0
    v_lshlrev_b32 v24, 3, v34
    v_mov_b32 v25, 8
    v_lshlrev_b32 v24, v24, v25
    v_sub_u32 v24, 0x0c0c0c0c, v24
    v_lshlrev_b32 v25, 4, v34
    v_bfe_u32 v34, v1, 4, 1
    v_lshl_add_u32 v25, v34, 2, v25
    v_bfe_u32 v34, v1, 5, 1
    v_lshl_add_u32 v25, v34, 1, v25
    s_waitcnt vmcnt(0)
L_poll:
    s_mov_b64 exec, s[76:77]
    buffer_load_dwordx4 v[68:71], v19, s[32:35], s70 offen sc0 sc1
    s_mov_b64 exec, s[78:79]
    buffer_load_dwordx4 v[72:75], v19, s[32:35], s71 offen sc0 sc1
    s_mov_b64 exec, s[80:81]
    buffer_load_dwordx4 v[76:79], v19, s[32:35], s72 offen sc0 sc1
    s_mov_b64 exec, -1
    s_waitcnt vmcnt(0)
    v_perm_b32 v36, v69, v68, s82
    v_perm_b32 v37, v73, v72, s82
    v_perm_b32 v38, v77, v76, s82
    v_perm_b32 v36, v70, v36, s83
    v_perm_b32 v37, v74, v37, s83
    v_perm_b32 v38, v78, v38, s83
    v_xor_b32 v36, s84, v36
    v_xor_b32 v37, s84, v37
    v_xor_b32 v38, s84, v38
    v_or_b32_dpp v36, v36, v36 quad_perm:[1,0,3,2] row_mask:0xf bank_mask:0xf
    v_or_b32_dpp v37, v37, v37 quad_perm:[1,0,3,2] row_mask:0xf bank_mask:0xf
    v_or_b32_dpp v38, v38, v38 quad_perm:[1,0,3,2] row_mask:0xf bank_mask:0xf
    v_or_b32_dpp v36, v36, v36 quad_perm:[2,3,0,1] row_mask:0xf bank_mask:0xf
    v_or_b32_dpp v37, v37, v37 quad_perm:[2,3,0,1] row_mask:0xf bank_mask:0xf
    v_or_b32_dpp v38, v38, v38 quad_perm:[2,3,0,1] row_mask:0xf bank_mask:0xf
    v_cmp_ne_u32 s[86:87], 0, v36
    v_cmp_ne_u32 s[74:75], 0, v37
    v_cmp_ne_u32 vcc, 0, v38
    s_and_b64 s[76:77], s[76:77], s[86:87]
    s_and_b64 s[78:79], s[78:79], s[74:75]
    s_and_b64 s[80:81], s[80:81], vcc
    s_or_b64 vcc, s[76:77], s[78:79]
    s_or_b64 vcc, vcc, s[80:81]
    s_cbranch_scc0 L_ready
    s_add_u32 s95, s95, 1
    s_cmp_gt_u32 s95, 200000
    s_cbranch_scc1 L_ready
    s_sleep 2
    s_branch L_poll
L_ready:
    v_perm_b32 v36, v71, v71, v24
    v_perm_b32 v37, v75, v75, v24
    v_perm_b32 v38, v79, v79, v24
    v_or_b32_dpp v36, v36, v36 quad_perm:[1,0,3,2] row_mask:0xf bank_mask:0xf
    v_or_b32_dpp v37, v37, v37 quad_perm:[1,0,3,2] row_mask:0xf bank_mask:0xf
    v_or_b32_dpp v38, v38, v38 quad_perm:[1,0,3,2] row_mask:0xf bank_mask:0xf
    v_or_b32_dpp v36, v36, v36 quad_perm:[2,3,0,1] row_mask:0xf bank_mask:0xf
    v_or_b32_dpp v37, v37, v37 quad_perm:[2,3,0,1] row_mask:0xf bank_mask:0xf
    v_or_b32_dpp v38, v38, v38 quad_perm:[2,3,0,1] row_mask:0xf bank_mask:0xf
    v_mov_b32 v29, 0xff800000
    s_nop 0
    v_cndmask_b32 v38, v29, v38, s[54:55]
    v_max3_f32 v28, v36, v37, v38
    s_nop 1
    v_max_f32_dpp v28, v28, v28 row_ror:4 row_mask:0xf bank_mask:0xf
    s_nop 1
    v_max_f32_dpp v28, v28, v28 row_ror:8 row_mask:0xf bank_mask:0xf
    v_mov_b32 v29, v28
    s_nop 1
    v_permlane16_swap_b32 v28, v29
    v_max_f32 v28, v28, v29
    v_mov_b32 v29, v28
    s_nop 1
    v_permlane32_swap_b32 v28, v29
    v_max_f32 v28, v28, v29
    v_sub_f32 v40, v36, v28
    v_sub_f32 v41, v37, v28
    v_sub_f32 v42, v38, v28
    v_exp_f32 v40, v40
    v_exp_f32 v41, v41
    v_exp_f32 v42, v42
    s_nop 0
    v_mul_f32 v44, v40, v68
    v_mul_f32 v45, v40, v69
    v_mul_f32 v46, v40, v70
    v_mul_f32 v47, v40, v71
    v_add_f32 v48, v40, v41
    v_fmac_f32 v44, v41, v72
    v_fmac_f32 v45, v41, v73
    v_fmac_f32 v46, v41, v74
    v_fmac_f32 v47, v41, v75
    v_add_f32 v48, v48, v42
    v_fmac_f32 v44, v42, v76
    v_fmac_f32 v45, v42, v77
    v_fmac_f32 v46, v42, v78
    v_fmac_f32 v47, v42, v79
    v_mov_b32 v49, v48
    s_nop 0
    v_permlane32_swap_b32 v44, v45
    v_permlane32_swap_b32 v48, v49
    v_permlane32_swap_b32 v46, v47
    v_add_f32 v44, v44, v45
    v_add_f32 v48, v48, v49
    v_add_f32 v46, v46, v47
    v_mov_b32 v49, v48
    s_nop 0
    v_permlane16_swap_b32 v44, v46
    v_permlane16_swap_b32 v48, v49
    v_add_f32 v44, v44, v46
    v_add_f32 v48, v48, v49
    s_nop 0
    v_add_f32_dpp v44, v44, v44 row_ror:4 row_mask:0xf bank_mask:0xf
    v_add_f32_dpp v48, v48, v48 row_ror:4 row_mask:0xf bank_mask:0xf
    s_nop 0
    v_add_f32_dpp v44, v44, v44 row_ror:8 row_mask:0xf bank_mask:0xf
    v_add_f32_dpp v48, v48, v48 row_ror:8 row_mask:0xf bank_mask:0xf
    s_bfe_u32 s74, s45, 0x20002
    s_lshl_b32 s74, s74, 5
    s_add_u32 s74, s74, s44
    s_lshl_b32 s74, s74, 8
    v_rcp_f32 v48, v48
    s_and_b32 s75, s45, 3
    s_lshl_b32 s75, s75, 6
    s_add_u32 s74, s74, s75
    s_lshr_b32 s75, s45, 4
    s_lshl_b32 s75, s75, 3
    s_add_u32 s74, s74, s75
    v_mul_f32 v44, v44, v48
    s_mov_b32 s80, s14
    s_and_b32 s81, s15, 0xffff
    s_mov_b32 s82, 32768
    s_mov_b32 s83, 0x00020000
    v_cvt_pk_bf16_f32 v44, v44, v44
    s_mov_b32 exec_lo, 0x000f000f
    s_mov_b32 exec_hi, 0x000f000f
    buffer_store_short v44, v25, s[80:83], s74 offen
L_end:
    s_endpgm
L_nohma:
    s_mul_i32 s70, s55, 64
    s_lshr_b32 s71, s47, 3
    s_sub_u32 s71, s71, s70
    s_mul_i32 s71, s71, 23
    s_lshr_b32 s71, s71, 10
    s_mul_i32 s72, s55, 2
    s_sub_u32 s73, 4, s72
    s_max_u32 s71, s71, s73
    s_lshl_b32 s73, s71, 5
    s_add_u32 s73, s73, s70
    s_lshl_b32 s66, s73, 3
    s_min_u32 s66, s66, s47
    s_mul_i32 s73, s45, s71
    s_add_u32 s73, s73, s70
    s_lshl_b32 s46, s73, 3
    s_mov_b32 s49, s71
    s_add_u32 s73, s45, s70
    s_lshl_b32 s46, s73, 3
    s_movk_i32 s13, 256
    s_branch L_schedreta
L_filla:
    s_sub_u32 s7, s7, 1
    s_cbranch_scc1 L_swf2a
L_swfret2a:
    s_min_u32 s48, s46, s47
    s_add_u32 s46, s46, s13
    s_sub_u32 s49, s49, 1
    v_mov_b32 v22, s48
    ds_read_b64 v[36:37], v22
    s_sub_u32 s7, s7, 1
    s_cbranch_scc1 L_swf3a
L_swfret3a:
    s_min_u32 s48, s46, s47
    s_add_u32 s46, s46, s13
    s_sub_u32 s49, s49, 1
    v_mov_b32 v22, s48
    ds_read_b64 v[38:39], v22
    s_waitcnt lgkmcnt(0)
    v_readfirstlane_b32 s72, v36
    v_readfirstlane_b32 s56, v37
    v_readfirstlane_b32 s73, v38
    v_readfirstlane_b32 s57, v39
    s_add_u32 s72, s72, s5
    s_add_u32 s73, s73, s5
    s_waitcnt vmcnt(0)
    s_mov_b32 s77, 1073741824
    buffer_load_dword v100, v108, s[32:35], s77 offen
    buffer_load_dwordx4 v[112:115], v2, s[20:23], s72 offen nt
    buffer_load_dwordx4 v[116:119], v3, s[20:23], s72 offen nt
    buffer_load_dwordx4 v[120:123], v4, s[20:23], s72 offen nt
    buffer_load_dwordx4 v[124:127], v5, s[20:23], s72 offen nt
    buffer_load_dwordx4 v[128:131], v6, s[24:27], s72 offen nt
    buffer_load_dwordx4 v[132:135], v7, s[24:27], s72 offen nt
    buffer_load_dwordx4 v[136:139], v8, s[24:27], s72 offen nt
    buffer_load_dwordx4 v[140:143], v9, s[24:27], s72 offen nt
    buffer_load_dword v101, v108, s[32:35], s77 offen
    buffer_load_dwordx4 v[144:147], v2, s[20:23], s73 offen nt
    buffer_load_dwordx4 v[148:151], v3, s[20:23], s73 offen nt
    buffer_load_dwordx4 v[152:155], v4, s[20:23], s73 offen nt
    buffer_load_dwordx4 v[156:159], v5, s[20:23], s73 offen nt
    buffer_load_dwordx4 v[160:163], v6, s[24:27], s73 offen nt
    buffer_load_dwordx4 v[164:167], v7, s[24:27], s73 offen nt
    buffer_load_dwordx4 v[168:171], v8, s[24:27], s73 offen nt
    buffer_load_dwordx4 v[172:175], v9, s[24:27], s73 offen nt
    s_branch L_goa
L_sw0a:
    s_mov_b32 s94, 0
    s_branch L_switcha
L_ndyn0a:
    s_lshl_b32 s70, s70, 3
    s_add_u32 s70, s70, s66
    s_min_u32 s70, s70, s47
    s_max_u32 s63, s63, s70
    s_mov_b32 s48, s63
    s_branch L_nret0a
L_xdyn0a:
    s_cmp_eq_u32 s62, 0
    s_cbranch_scc1 L_xspin0a
L_xgo0a:
    s_cmp_eq_u32 s63, s47
    s_cselect_b32 s68, 1073741824, s67
    v_mov_b32 v100, 1
    buffer_atomic_add v100, v108, s[32:35], s68 offen sc0
    s_branch L_xret0a
L_xspin0a:
    buffer_load_dword v19, v108, s[28:31], s69 offen sc0 sc1
    s_waitcnt vmcnt(0)
    v_readfirstlane_b32 s62, v19
    s_sleep 4
    s_add_u32 s95, s95, 1
    s_cmp_gt_u32 s95, 200000
    s_cselect_b32 s62, 1, s62
    s_cmp_eq_u32 s62, 0
    s_cbranch_scc1 L_xspin0a
    s_branch L_xgo0a
L_part0a:
    s_and_b32 s55, s53, 0x1fff
    v_subrev_u32 v19, s55, v14
    v_sub_u32 v19, v19, v15
    v_mov_b32 v34, 0xff800000
    v_cmp_lt_i32 vcc, 0, v19
    s_nop 1
    v_cndmask_b32 v28, v34, v28, vcc
    v_cmp_lt_i32 vcc, 4, v19
    s_nop 1
    v_cndmask_b32 v29, v34, v29, vcc
    v_cmp_lt_i32 vcc, 8, v19
    s_nop 1
    v_cndmask_b32 v30, v34, v30, vcc
    v_cmp_lt_i32 vcc, 12, v19
    s_nop 1
    v_cndmask_b32 v31, v34, v31, vcc
    s_branch L_partret0a
L_slow0a:
    v_mov_b32 v34, 0xff7fffff
    v_cmp_lt_f32 vcc, 0xefa18f08, v28
    v_mul_f32 v28, s50, v24
    s_nop 0
    v_cndmask_b32 v28, v34, v28, vcc
    v_cmp_lt_f32 vcc, 0xefa18f08, v29
    v_mul_f32 v29, s50, v25
    s_nop 0
    v_cndmask_b32 v29, v34, v29, vcc
    v_cmp_lt_f32 vcc, 0xefa18f08, v30
    v_mul_f32 v30, s50, v26
    s_nop 0
    v_cndmask_b32 v30, v34, v30, vcc
    v_cmp_lt_f32 vcc, 0xefa18f08, v31
    v_mul_f32 v31, s50, v27
    s_nop 0
    v_cndmask_b32 v31, v34, v31, vcc
    v_max3_f32 v19, v28, v29, v30
    v_max_f32 v19, v19, v31
    v_mov_b32 v34, v19
    s_nop 1
    v_permlane16_swap_b32 v19, v34
    s_nop 1
    v_max_f32 v19, v19, v34
    v_mov_b32 v34, v19
    s_nop 1
    v_permlane32_swap_b32 v19, v34
    s_nop 1
    v_max3_f32 v19, v19, v34, v16
    v_sub_f32 v34, v16, v19
    v_exp_f32 v34, v34
    v_mov_b32 v16, v19
    v_mul_f32 v17, v17, v34
    ds_bpermute_b32 v19, v35, v34
    v_cndmask_b32 v18, v23, v16, s[64:65]
    s_waitcnt lgkmcnt(0)
    v_mul_f32 v68, v68, v19
    v_mul_f32 v72, v72, v19
    v_mul_f32 v76, v76, v19
    v_mul_f32 v80, v80, v19
    v_mul_f32 v84, v84, v19
    v_mul_f32 v88, v88, v19
    v_mul_f32 v92, v92, v19
    v_mul_f32 v96, v96, v19
    s_branch L_redo0a
L_sw1a:
    s_mov_b32 s94, 1
    s_branch L_switcha
L_ndyn1a:
    s_lshl_b32 s70, s70, 3
    s_add_u32 s70, s70, s66
    s_min_u32 s70, s70, s47
    s_max_u32 s63, s63, s70
    s_mov_b32 s48, s63
    s_branch L_nret1a
L_xdyn1a:
    s_cmp_eq_u32 s62, 0
    s_cbranch_scc1 L_xspin1a
L_xgo1a:
    s_cmp_eq_u32 s63, s47
    s_cselect_b32 s68, 1073741824, s67
    v_mov_b32 v101, 1
    buffer_atomic_add v101, v108, s[32:35], s68 offen sc0
    s_branch L_xret1a
L_xspin1a:
    buffer_load_dword v19, v108, s[28:31], s69 offen sc0 sc1
    s_waitcnt vmcnt(0)
    v_readfirstlane_b32 s62, v19
    s_sleep 4
    s_add_u32 s95, s95, 1
    s_cmp_gt_u32 s95, 200000
    s_cselect_b32 s62, 1, s62
    s_cmp_eq_u32 s62, 0
    s_cbranch_scc1 L_xspin1a
    s_branch L_xgo1a
L_part1a:
    s_and_b32 s55, s53, 0x1fff
    v_subrev_u32 v19, s55, v14
    v_sub_u32 v19, v19, v15
    v_mov_b32 v34, 0xff800000
    v_cmp_lt_i32 vcc, 0, v19
    s_nop 1
    v_cndmask_b32 v28, v34, v28, vcc
    v_cmp_lt_i32 vcc, 4, v19
    s_nop 1
    v_cndmask_b32 v29, v34, v29, vcc
    v_cmp_lt_i32 vcc, 8, v19
    s_nop 1
    v_cndmask_b32 v30, v34, v30, vcc
    v_cmp_lt_i32 vcc, 12, v19
    s_nop 1
    v_cndmask_b32 v31, v34, v31, vcc
    s_branch L_partret1a
L_slow1a:
    v_mov_b32 v34, 0xff7fffff
    v_cmp_lt_f32 vcc, 0xefa18f08, v28
    v_mul_f32 v28, s50, v24
    s_nop 0
    v_cndmask_b32 v28, v34, v28, vcc
    v_cmp_lt_f32 vcc, 0xefa18f08, v29
    v_mul_f32 v29, s50, v25
    s_nop 0
    v_cndmask_b32 v29, v34, v29, vcc
    v_cmp_lt_f32 vcc, 0xefa18f08, v30
    v_mul_f32 v30, s50, v26
    s_nop 0
    v_cndmask_b32 v30, v34, v30, vcc
    v_cmp_lt_f32 vcc, 0xefa18f08, v31
    v_mul_f32 v31, s50, v27
    s_nop 0
    v_cndmask_b32 v31, v34, v31, vcc
    v_max3_f32 v19, v28, v29, v30
    v_max_f32 v19, v19, v31
    v_mov_b32 v34, v19
    s_nop 1
    v_permlane16_swap_b32 v19, v34
    s_nop 1
    v_max_f32 v19, v19, v34
    v_mov_b32 v34, v19
    s_nop 1
    v_permlane32_swap_b32 v19, v34
    s_nop 1
    v_max3_f32 v19, v19, v34, v16
    v_sub_f32 v34, v16, v19
    v_exp_f32 v34, v34
    v_mov_b32 v16, v19
    v_mul_f32 v17, v17, v34
    ds_bpermute_b32 v19, v35, v34
    v_cndmask_b32 v18, v23, v16, s[64:65]
    s_waitcnt lgkmcnt(0)
    v_mul_f32 v68, v68, v19
    v_mul_f32 v72, v72, v19
    v_mul_f32 v76, v76, v19
    v_mul_f32 v80, v80, v19
    v_mul_f32 v84, v84, v19
    v_mul_f32 v88, v88, v19
    v_mul_f32 v92, v92, v19
    v_mul_f32 v96, v96, v19
    s_branch L_redo1a
L_switcha:
    s_nop 7
    v_mov_b32 v34, v17
    s_mov_b32 s72, 0x7060500
    s_mov_b32 s73, 0x7060501
    s_mov_b32 s74, 0x7060502
    v_permlane16_swap_b32 v17, v34
    v_mov_b32_dpp v29, v16 row_newbcast:0 row_mask:0x1 bank_mask:0xf
    v_mov_b32_dpp v29, v16 row_newbcast:4 row_mask:0x2 bank_mask:0xf
    v_mov_b32_dpp v29, v16 row_newbcast:8 row_mask:0x4 bank_mask:0xf
    v_mov_b32_dpp v29, v16 row_newbcast:12 row_mask:0x8 bank_mask:0xf
    v_add_f32 v17, v17, v34
    v_mov_b32 v34, v17
    v_lshlrev_b32 v22, 4, v1
    v_and_b32 v32, 3, v1
    v_permlane32_swap_b32 v17, v34
    v_lshlrev_b32 v32, 3, v32
    v_add_f32 v17, v17, v34
    s_cmp_lg_u32 s62, 0
    s_cbranch_scc1 L_havenonce_swa
L_nspin_swa:
    buffer_load_dword v19, v108, s[28:31], s69 offen sc0 sc1
    s_waitcnt vmcnt(0)
    v_readfirstlane_b32 s62, v19
    s_sleep 4
    s_add_u32 s95, s95, 1
    s_cmp_gt_u32 s95, 200000
    s_cselect_b32 s62, 1, s62
    s_cmp_eq_u32 s62, 0
    s_cbranch_scc1 L_nspin_swa
L_havenonce_swa:
    v_mov_b32 v20, s62
    s_nop 0
    v_mov_b32_dpp v28, v17 row_newbcast:0 row_mask:0x1 bank_mask:0xf
    v_mov_b32_dpp v28, v17 row_newbcast:4 row_mask:0x2 bank_mask:0xf
    v_mov_b32_dpp v28, v17 row_newbcast:8 row_mask:0x4 bank_mask:0xf
    v_mov_b32_dpp v28, v17 row_newbcast:12 row_mask:0x8 bank_mask:0xf
    v_rcp_f32 v30, v28
    v_log_f32 v31, v28
    v_cmp_lt_f32 vcc, 0, v28
    s_nop 0
    v_add_f32 v31, v31, v29
    v_cndmask_b32 v30, 0, v30, vcc
    v_lshrrev_b32 v21, v32, v31
    v_mul_f32 v36, v68, v30
    v_mul_f32 v37, v72, v30
    v_mul_f32 v38, v76, v30
    v_mul_f32 v39, v80, v30
    v_perm_b32 v52, v36, v20, s72
    v_perm_b32 v53, v37, v20, s73
    v_perm_b32 v54, v38, v20, s74
    v_perm_b32 v55, v39, v21, s72
    buffer_store_dwordx4 v[52:55], v22, s[32:35], s10 offen offset:0 sc0 sc1
    v_mul_f32 v40, v84, v30
    v_mul_f32 v41, v88, v30
    v_mul_f32 v42, v92, v30
    v_mul_f32 v43, v96, v30
    v_perm_b32 v56, v40, v20, s72
    v_perm_b32 v57, v41, v20, s73
    v_perm_b32 v58, v42, v20, s74
    v_perm_b32 v59, v43, v21, s72
    buffer_store_dwordx4 v[56:59], v22, s[32:35], s10 offen offset:1024 sc0 sc1
    v_mov_b32 v16, 0xf149f2ca
    v_mov_b32 v17, 0
    v_mov_b32 v10, v104
    v_mov_b32 v11, v105
    v_mov_b32 v12, v106
    v_mov_b32 v13, v107
    v_mov_b32 v68, 0
    v_mov_b32 v69, 0
    v_mov_b32 v70, 0
    v_mov_b32 v71, 0
    v_mov_b32 v72, 0
    v_mov_b32 v73, 0
    v_mov_b32 v74, 0
    v_mov_b32 v75, 0
    v_mov_b32 v76, 0
    v_mov_b32 v77, 0
    v_mov_b32 v78, 0
    v_mov_b32 v79, 0
    v_mov_b32 v80, 0
    v_mov_b32 v81, 0
    v_mov_b32 v82, 0
    v_mov_b32 v83, 0
    v_mov_b32 v84, 0
    v_mov_b32 v85, 0
    v_mov_b32 v86, 0
    v_mov_b32 v87, 0
    v_mov_b32 v88, 0
    v_mov_b32 v89, 0
    v_mov_b32 v90, 0
    v_mov_b32 v91, 0
    v_mov_b32 v92, 0
    v_mov_b32 v93, 0
    v_mov_b32 v94, 0
    v_mov_b32 v95, 0
    v_mov_b32 v96, 0
    v_mov_b32 v97, 0
    v_mov_b32 v98, 0
    v_mov_b32 v99, 0
    s_mov_b32 s8, 2147483647
    s_cmp_eq_u32 s94, 0
    s_cbranch_scc1 L_swret0a
    s_branch L_swret1a
L_swf1a:
    s_mov_b32 s46, s9
    s_movk_i32 s13, 256
    s_mov_b32 s13, s37
    s_lshl_b32 s5, s44, 8
    s_mov_b32 s7, s36
    s_mov_b32 s36, 2147483647
    s_movk_i32 s37, 128
    s_mov_b32 s9, s38
    s_branch L_swfret1a
L_swf2a:
    s_mov_b32 s46, s9
    s_movk_i32 s13, 256
    s_mov_b32 s13, s37
    s_lshl_b32 s5, s44, 8
    s_mov_b32 s7, s36
    s_mov_b32 s36, 2147483647
    s_movk_i32 s37, 128
    s_mov_b32 s9, s38
    s_branch L_swfret2a
L_swf3a:
    s_mov_b32 s46, s9
    s_movk_i32 s13, 256
    s_mov_b32 s13, s37
    s_lshl_b32 s5, s44, 8
    s_mov_b32 s7, s36
    s_mov_b32 s36, 2147483647
    s_movk_i32 s37, 128
    s_mov_b32 s9, s38
    s_branch L_swfret3a
L_swf4a:
    s_mov_b32 s46, s9
    s_movk_i32 s13, 256
    s_mov_b32 s13, s37
    s_lshl_b32 s5, s44, 8
    s_mov_b32 s7, s36
    s_mov_b32 s36, 2147483647
    s_movk_i32 s37, 128
    s_mov_b32 s9, s38
    s_branch L_swfret4a
L_swf5a:
    s_mov_b32 s46, s9
    s_movk_i32 s13, 256
    s_mov_b32 s13, s37
    s_lshl_b32 s5, s44, 8
    s_mov_b32 s7, s36
    s_mov_b32 s36, 2147483647
    s_movk_i32 s37, 128
    s_mov_b32 s9, s38
    s_branch L_swfret5a
.section .rodata,"a"
.p2align 6
.amdhsa_kernel standalone__paged_block_table_kv_radixattention__decode_kernel
  .amdhsa_next_free_vgpr 176
  .amdhsa_next_free_sgpr 102
  .amdhsa_accum_offset 176
  .amdhsa_group_segment_fixed_size 0
  .amdhsa_kernarg_size 64
  .amdhsa_user_sgpr_count 2
  .amdhsa_user_sgpr_kernarg_segment_ptr 1
  .amdhsa_system_sgpr_workgroup_id_x 1
.end_amdhsa_kernel
```
